```python
import torch

def _softmax(x, axis=-1):
    return torch.softmax(x, dim=axis)
def _gelu(x):
    return torch.nn.functional.gelu(x, approximate="tanh")
def _silu(x):
    return torch.nn.functional.silu(x)
def _sigmoid(x):
    return torch.sigmoid(x)
def _layernorm(x, axis=-1, eps=1e-5):
    m = x.mean(dim=axis, keepdim=True)
    v = x.var(dim=axis, keepdim=True, unbiased=False)
    return (x - m) / torch.sqrt(v + eps)
def _scatter_add(tgt, idx, src, axis=0):
    return tgt.clone().index_add_(axis, idx, src)
def _segment_sum(src, seg, n):
    out = torch.zeros((n,) + src.shape[1:], dtype=src.dtype)
    return out.index_add_(0, seg, src)
def _pad(x, pw):
    flat = tuple(v for pair in reversed(pw) for v in pair)
    return torch.nn.functional.pad(x, flat)

kernel_name = 'standalone__gqa_softmax__near_ridge'

def setup_inputs():

    _w = (lambda a: (lambda t: t.to(torch.bfloat16) if t.is_floating_point() else t)(torch.as_tensor(a)))
    B, Hq, Hkv, Sq, Sk, D = 8, 32, 4, 48, 2048, 128
    return {
        "q": _w((lambda *s: torch.randn(*s, dtype=torch.bfloat16) * 0.8)(B, Hq, Sq, D)),
        "k": _w((lambda *s: torch.randn(*s, dtype=torch.bfloat16) * 0.8)(B, Hkv, Sk, D)),
        "v": _w((lambda *s: torch.randn(*s, dtype=torch.bfloat16) * 0.05)(B, Hkv, Sk, D)),
    }

def reference(q, k, v):
    B, Hq, Sq, D = q.shape
    Hkv = k.shape[1]
    rep = Hq // Hkv
    k = (lambda x, n, axis: torch.repeat_interleave(x, n, dim=axis))(k, rep, axis=1)
    v = (lambda x, n, axis: torch.repeat_interleave(x, n, dim=axis))(v, rep, axis=1)
    scale = D ** -0.5
    scores = torch.einsum("bhqd,bhkd->bhqk", q, k) * scale
    p = _softmax(scores, axis=-1)
    return torch.einsum("bhqk,bhkd->bhqd", p, v)
```

```asm
; @launch grid=(256,1,1) block=(512,1,1) lds=147456
.amdgcn_target "amdgcn-amd-amdhsa--gfx950"
.text
.globl standalone__gqa_softmax__near_ridge_kernel
.p2align 8
.type standalone__gqa_softmax__near_ridge_kernel,@function
standalone__gqa_softmax__near_ridge_kernel:
  s_cmp_ge_u32 s2, 256
  s_cbranch_scc1 L_end
  s_load_dwordx8 s[4:11], s[0:1], 0
  s_getpc_b64 s[44:45]
L_pc0:
  v_and_b32 v40, 63, v0
  v_lshlrev_b32 v40, 7, v40
  v_min_u32 v40, L_codeend-L_pc0, v40
  v_mov_b32 v41, s45
  v_add_co_u32 v40, vcc, s44, v40
  v_addc_co_u32 v41, vcc, 0, v41, vcc
  global_load_dword v33, v[40:41], off
  v_and_b32 v40, 63, v0
  v_lshrrev_b32 v41, 6, v0
  s_nop 0
  v_readfirstlane_b32 s28, v41
  s_and_b32 s37, s2, 7
  s_lshr_b32 s38, s2, 3
  s_lshr_b32 s39, s38, 3
  s_lshl_b32 s37, s37, 2
  s_add_u32 s37, s37, s39
  s_and_b32 s29, s38, 7
  s_lshl_b32 s39, s37, 3
  s_add_u32 s39, s39, s29
  s_mul_i32 s40, s39, 12288
  s_lshl_b32 s41, s37, 19
  v_and_b32 v42, 15, v40
  v_lshrrev_b32 v43, 4, v40
  v_lshlrev_b32 v44, 1, v43
  v_xor_b32 v45, v42, v44
  v_lshlrev_b32 v46, 8, v43
  v_lshl_add_u32 v1, v45, 4, v46
  v_xor_b32 v45, 8, v45
  v_lshl_add_u32 v2, v45, 4, v46
  v_add_u32 v45, 0, v43
  v_xor_b32 v45, v42, v45
  v_lshl_add_u32 v3, v45, 4, v46
  v_add_u32 v45, 4, v43
  v_xor_b32 v45, v42, v45
  v_lshl_add_u32 v4, v45, 4, v46
  v_add_u32 v45, 8, v43
  v_xor_b32 v45, v42, v45
  v_lshl_add_u32 v5, v45, 4, v46
  v_add_u32 v45, 12, v43
  v_xor_b32 v45, v42, v45
  v_lshl_add_u32 v6, v45, 4, v46
  s_lshl_b32 s32, s28, 14
  v_lshlrev_b32 v46, 8, v42
  v_add_u32 v47, s32, v46
  v_add_u32 v45, 0, v43
  v_xor_b32 v45, v42, v45
  v_lshl_add_u32 v7, v45, 4, v47
  v_add_u32 v45, 4, v43
  v_xor_b32 v45, v42, v45
  v_lshl_add_u32 v8, v45, 4, v47
  v_add_u32 v45, 8, v43
  v_xor_b32 v45, v42, v45
  v_lshl_add_u32 v9, v45, 4, v47
  v_add_u32 v45, 12, v43
  v_xor_b32 v45, v42, v45
  v_lshl_add_u32 v10, v45, 4, v47
  v_lshrrev_b32 v44, 2, v42
  v_and_b32 v45, 3, v42
  v_lshl_add_u32 v46, v43, 2, v44
  v_and_b32 v47, 7, v46
  v_lshlrev_b32 v48, 8, v46
  v_lshrrev_b32 v49, 1, v45
  v_lshl_add_u32 v48, v49, 4, v48
  v_and_b32 v49, 1, v45
  v_lshl_add_u32 v48, v49, 3, v48
  s_add_u32 s34, s32, 8192
  v_add_u32 v48, s34, v48
  v_xor_b32 v49, 0, v47
  v_lshl_add_u32 v11, v49, 5, v48
  v_xor_b32 v49, 1, v47
  v_lshl_add_u32 v12, v49, 5, v48
  v_xor_b32 v49, 2, v47
  v_lshl_add_u32 v13, v49, 5, v48
  v_xor_b32 v49, 3, v47
  v_lshl_add_u32 v14, v49, 5, v48
  v_xor_b32 v49, 4, v47
  v_lshl_add_u32 v15, v49, 5, v48
  v_xor_b32 v49, 5, v47
  v_lshl_add_u32 v16, v49, 5, v48
  v_xor_b32 v49, 6, v47
  v_lshl_add_u32 v17, v49, 5, v48
  v_xor_b32 v49, 7, v47
  v_lshl_add_u32 v18, v49, 5, v48
  s_waitcnt lgkmcnt(0)
  s_add_u32 s12, s4, s40
  s_addc_u32 s13, s5, 0
  s_mov_b32 s14, 12288
  s_mov_b32 s15, 0x00020000
  s_add_u32 s16, s6, s41
  s_addc_u32 s17, s7, 0
  s_mov_b32 s18, 524288
  s_mov_b32 s19, 0x00020000
  s_add_u32 s20, s8, s41
  s_addc_u32 s21, s9, 0
  s_mov_b32 s22, 524288
  s_mov_b32 s23, 0x00020000
  s_add_u32 s24, s10, s40
  s_addc_u32 s25, s11, 0
  s_mov_b32 s26, 12288
  s_mov_b32 s27, 0x00020000
  s_lshl_b32 s30, s28, 16
  s_and_b32 s29, s29, 1
  s_lshl_b32 s29, s29, 2
  s_mov_b32 s31, 0x3e0293ee
  s_mov_b32 s33, 0
  v_mov_b32 v40, 0
  buffer_load_dword v34, v40, s[24:27], 0 offen
  s_cmp_ge_u32 s28, 4
  s_cbranch_scc1 L_pB
  s_add_u32 s42, s33, s29
  s_and_b32 s42, s42, 7
  s_lshl_b32 s42, s42, 13
  s_add_u32 s42, s42, s30
  s_add_u32 s35, s32, 0
  s_mov_b32 m0, s35
  s_add_u32 s34, s42, 4096
  buffer_load_dwordx4 v3, s[16:19], s42 offen offset:0  lds
  buffer_load_dwordx4 v4, s[16:19], s42 offen offset:1024  lds
  buffer_load_dwordx4 v5, s[16:19], s42 offen offset:2048  lds
  buffer_load_dwordx4 v6, s[16:19], s42 offen offset:3072  lds
  s_add_u32 s35, s35, 4096
  s_mov_b32 m0, s35
  s_nop 0
  buffer_load_dwordx4 v3, s[16:19], s34 offen offset:0  lds
  buffer_load_dwordx4 v4, s[16:19], s34 offen offset:1024  lds
  buffer_load_dwordx4 v5, s[16:19], s34 offen offset:2048  lds
  buffer_load_dwordx4 v6, s[16:19], s34 offen offset:3072  lds
  s_add_u32 s42, s33, s29
  s_and_b32 s42, s42, 7
  s_lshl_b32 s42, s42, 13
  s_add_u32 s42, s42, s30
  s_add_u32 s35, s32, 8192
  s_mov_b32 m0, s35
  s_add_u32 s34, s42, 4096
  buffer_load_dwordx4 v1, s[20:23], s42 offen offset:0  lds
  buffer_load_dwordx4 v2, s[20:23], s42 offen offset:1024  lds
  buffer_load_dwordx4 v1, s[20:23], s42 offen offset:2048  lds
  buffer_load_dwordx4 v2, s[20:23], s42 offen offset:3072  lds
  s_add_u32 s35, s35, 4096
  s_mov_b32 m0, s35
  s_nop 0
  buffer_load_dwordx4 v1, s[20:23], s34 offen offset:0  lds
  buffer_load_dwordx4 v2, s[20:23], s34 offen offset:1024  lds
  buffer_load_dwordx4 v1, s[20:23], s34 offen offset:2048  lds
  buffer_load_dwordx4 v2, s[20:23], s34 offen offset:3072  lds
  s_branch L_noq
L_pB:
  s_cmp_lt_u32 s28, 5
  s_cbranch_scc1 L_pB2
  s_sub_u32 s36, s28, 5
  s_lshl_b32 s34, s36, 12
  s_add_u32 s35, s34, 131072
  s_mov_b32 m0, s35
  s_nop 0
  buffer_load_dwordx4 v3, s[12:15], s34 offen offset:0 lds
  buffer_load_dwordx4 v4, s[12:15], s34 offen offset:1024 lds
  buffer_load_dwordx4 v5, s[12:15], s34 offen offset:2048 lds
  buffer_load_dwordx4 v6, s[12:15], s34 offen offset:3072 lds
L_pB2:
  s_add_u32 s42, s33, s29
  s_and_b32 s42, s42, 7
  s_lshl_b32 s42, s42, 13
  s_add_u32 s42, s42, s30
  s_add_u32 s35, s32, 8192
  s_mov_b32 m0, s35
  s_add_u32 s34, s42, 4096
  buffer_load_dwordx4 v1, s[20:23], s42 offen offset:0  lds
  buffer_load_dwordx4 v2, s[20:23], s42 offen offset:1024  lds
  buffer_load_dwordx4 v1, s[20:23], s42 offen offset:2048  lds
  buffer_load_dwordx4 v2, s[20:23], s42 offen offset:3072  lds
  s_add_u32 s35, s35, 4096
  s_mov_b32 m0, s35
  s_nop 0
  buffer_load_dwordx4 v1, s[20:23], s34 offen offset:0  lds
  buffer_load_dwordx4 v2, s[20:23], s34 offen offset:1024  lds
  buffer_load_dwordx4 v1, s[20:23], s34 offen offset:2048  lds
  buffer_load_dwordx4 v2, s[20:23], s34 offen offset:3072  lds
  s_add_u32 s42, s33, s29
  s_and_b32 s42, s42, 7
  s_lshl_b32 s42, s42, 13
  s_add_u32 s42, s42, s30
  s_add_u32 s35, s32, 0
  s_mov_b32 m0, s35
  s_add_u32 s34, s42, 4096
  buffer_load_dwordx4 v3, s[16:19], s42 offen offset:0  lds
  buffer_load_dwordx4 v4, s[16:19], s42 offen offset:1024  lds
  buffer_load_dwordx4 v5, s[16:19], s42 offen offset:2048  lds
  buffer_load_dwordx4 v6, s[16:19], s42 offen offset:3072  lds
  s_add_u32 s35, s35, 4096
  s_mov_b32 m0, s35
  s_nop 0
  buffer_load_dwordx4 v3, s[16:19], s34 offen offset:0  lds
  buffer_load_dwordx4 v4, s[16:19], s34 offen offset:1024  lds
  buffer_load_dwordx4 v5, s[16:19], s34 offen offset:2048  lds
  buffer_load_dwordx4 v6, s[16:19], s34 offen offset:3072  lds
L_noq:
  v_mov_b32 v160, 0
  v_mov_b32 v161, 0
  v_mov_b32 v162, 0
  v_mov_b32 v163, 0
  v_mov_b32 v164, 0
  v_mov_b32 v165, 0
  v_mov_b32 v166, 0
  v_mov_b32 v167, 0
  v_mov_b32 v168, 0
  v_mov_b32 v169, 0
  v_mov_b32 v170, 0
  v_mov_b32 v171, 0
  v_mov_b32 v172, 0
  v_mov_b32 v173, 0
  v_mov_b32 v174, 0
  v_mov_b32 v175, 0
  v_mov_b32 v176, 0
  v_mov_b32 v177, 0
  v_mov_b32 v178, 0
  v_mov_b32 v179, 0
  v_mov_b32 v180, 0
  v_mov_b32 v181, 0
  v_mov_b32 v182, 0
  v_mov_b32 v183, 0
  v_mov_b32 v184, 0
  v_mov_b32 v185, 0
  v_mov_b32 v186, 0
  v_mov_b32 v187, 0
  v_mov_b32 v188, 0
  v_mov_b32 v189, 0
  v_mov_b32 v190, 0
  v_mov_b32 v191, 0
  v_mov_b32 v192, 0
  v_mov_b32 v193, 0
  v_mov_b32 v194, 0
  v_mov_b32 v195, 0
  v_mov_b32 v196, 0
  v_mov_b32 v197, 0
  v_mov_b32 v198, 0
  v_mov_b32 v199, 0
  v_mov_b32 v200, 0
  v_mov_b32 v201, 0
  v_mov_b32 v202, 0
  v_mov_b32 v203, 0
  v_mov_b32 v204, 0
  v_mov_b32 v205, 0
  v_mov_b32 v206, 0
  v_mov_b32 v207, 0
  v_mov_b32 v208, 0
  v_mov_b32 v209, 0
  v_mov_b32 v210, 0
  v_mov_b32 v211, 0
  v_mov_b32 v212, 0
  v_mov_b32 v213, 0
  v_mov_b32 v214, 0
  v_mov_b32 v215, 0
  v_mov_b32 v216, 0
  v_mov_b32 v217, 0
  v_mov_b32 v218, 0
  v_mov_b32 v219, 0
  v_mov_b32 v220, 0
  v_mov_b32 v221, 0
  v_mov_b32 v222, 0
  v_mov_b32 v223, 0
  v_mov_b32 v224, 0
  v_mov_b32 v225, 0
  v_mov_b32 v226, 0
  v_mov_b32 v227, 0
  v_mov_b32 v228, 0
  v_mov_b32 v229, 0
  v_mov_b32 v230, 0
  v_mov_b32 v231, 0
  v_mov_b32 v232, 0
  v_mov_b32 v233, 0
  v_mov_b32 v234, 0
  v_mov_b32 v235, 0
  v_mov_b32 v236, 0
  v_mov_b32 v237, 0
  v_mov_b32 v238, 0
  v_mov_b32 v239, 0
  v_mov_b32 v240, 0
  v_mov_b32 v241, 0
  v_mov_b32 v242, 0
  v_mov_b32 v243, 0
  v_mov_b32 v244, 0
  v_mov_b32 v245, 0
  v_mov_b32 v246, 0
  v_mov_b32 v247, 0
  v_mov_b32 v248, 0
  v_mov_b32 v249, 0
  v_mov_b32 v250, 0
  v_mov_b32 v251, 0
  v_mov_b32 v252, 0
  v_mov_b32 v253, 0
  v_mov_b32 v254, 0
  v_mov_b32 v255, 0
  v_mov_b32 v19, 0xff800000
  v_mov_b32 v22, 0
  v_mov_b32 v20, 0xff800000
  v_mov_b32 v23, 0
  v_mov_b32 v21, 0xff800000
  v_mov_b32 v24, 0
  s_sub_u32 s34, 131072, s32
  v_add_u32 v40, s34, v7
  v_add_u32 v41, s34, v8
  v_add_u32 v42, s34, v9
  v_add_u32 v43, s34, v10
  s_waitcnt vmcnt(0)
  s_barrier
  ds_read_b128 v[112:115], v40 offset:0
  ds_read_b128 v[116:119], v41 offset:0
  ds_read_b128 v[120:123], v42 offset:0
  ds_read_b128 v[124:127], v43 offset:0
  ds_read_b128 v[128:131], v40 offset:4096
  ds_read_b128 v[132:135], v41 offset:4096
  ds_read_b128 v[136:139], v42 offset:4096
  ds_read_b128 v[140:143], v43 offset:4096
  ds_read_b128 v[144:147], v40 offset:8192
  ds_read_b128 v[148:151], v41 offset:8192
  ds_read_b128 v[152:155], v42 offset:8192
  ds_read_b128 v[156:159], v43 offset:8192
  s_waitcnt lgkmcnt(0)
L_loop:
  s_waitcnt vmcnt(8)
  ds_read_b128 v[80:83], v7 offset:0
  ds_read_b128 v[84:87], v8 offset:0
  ds_read_b128 v[88:91], v9 offset:0
  ds_read_b128 v[92:95], v10 offset:0
  ds_read_b128 v[96:99], v7 offset:4096
  ds_read_b128 v[100:103], v8 offset:4096
  ds_read_b128 v[104:107], v9 offset:4096
  ds_read_b128 v[108:111], v10 offset:4096
  s_waitcnt lgkmcnt(0)
  s_add_u32 s42, s33, s29
  s_add_u32 s42, s42, 1
  s_and_b32 s42, s42, 7
  s_lshl_b32 s42, s42, 13
  s_add_u32 s42, s42, s30
  s_cmp_lt_u32 s33, 7
  s_cselect_b32 s18, 524288, 0
  s_add_u32 s35, s32, 0
  s_mov_b32 m0, s35
  s_add_u32 s34, s42, 4096
  v_mfma_f32_16x16x32_bf16 v[56:59], v[80:83], v[112:115], 0
  buffer_load_dwordx4 v3, s[16:19], s42 offen offset:0  lds
  v_mfma_f32_16x16x32_bf16 v[68:71], v[96:99], v[112:115], 0
  buffer_load_dwordx4 v4, s[16:19], s42 offen offset:1024  lds
  v_mfma_f32_16x16x32_bf16 v[56:59], v[84:87], v[116:119], v[56:59]
  buffer_load_dwordx4 v5, s[16:19], s42 offen offset:2048  lds
  v_mfma_f32_16x16x32_bf16 v[68:71], v[100:103], v[116:119], v[68:71]
  buffer_load_dwordx4 v6, s[16:19], s42 offen offset:3072  lds
  v_mfma_f32_16x16x32_bf16 v[56:59], v[88:91], v[120:123], v[56:59]
  s_add_u32 s35, s35, 4096
  s_mov_b32 m0, s35
  s_nop 0
  buffer_load_dwordx4 v3, s[16:19], s34 offen offset:0  lds
  v_mfma_f32_16x16x32_bf16 v[68:71], v[104:107], v[120:123], v[68:71]
  buffer_load_dwordx4 v4, s[16:19], s34 offen offset:1024  lds
  v_mfma_f32_16x16x32_bf16 v[56:59], v[92:95], v[124:127], v[56:59]
  buffer_load_dwordx4 v5, s[16:19], s34 offen offset:2048  lds
  v_mfma_f32_16x16x32_bf16 v[68:71], v[108:111], v[124:127], v[68:71]
  buffer_load_dwordx4 v6, s[16:19], s34 offen offset:3072  lds
  s_nop 3
  v_mfma_f32_16x16x32_bf16 v[60:63], v[80:83], v[128:131], 0
  v_mfma_f32_16x16x32_bf16 v[72:75], v[96:99], v[128:131], 0
  v_mfma_f32_16x16x32_bf16 v[60:63], v[84:87], v[132:135], v[60:63]
  s_nop 3
  v_fma_f32 v32, v56, s31, -v19
  v_fma_f32 v33, v57, s31, -v19
  v_fma_f32 v34, v58, s31, -v19
  v_fma_f32 v35, v59, s31, -v19
  v_fma_f32 v36, v68, s31, -v19
  v_mfma_f32_16x16x32_bf16 v[72:75], v[100:103], v[132:135], v[72:75]
  v_fma_f32 v37, v69, s31, -v19
  v_fma_f32 v38, v70, s31, -v19
  v_fma_f32 v39, v71, s31, -v19
  v_max3_f32 v25, v32, v33, v34
  v_mfma_f32_16x16x32_bf16 v[60:63], v[88:91], v[136:139], v[60:63]
  v_max3_f32 v26, v35, v36, v37
  v_max3_f32 v25, v25, v38, v39
  v_max_f32 v25, v25, v26
  v_cmp_lt_f32 vcc, 0x41000000, v25
  v_mfma_f32_16x16x32_bf16 v[72:75], v[104:107], v[136:139], v[72:75]
  s_cbranch_vccnz L_slowa
L_backa:
  v_exp_f32 v32, v32
  v_exp_f32 v33, v33
  v_mfma_f32_16x16x32_bf16 v[60:63], v[92:95], v[140:143], v[60:63]
  v_exp_f32 v34, v34
  v_exp_f32 v35, v35
  v_mfma_f32_16x16x32_bf16 v[72:75], v[108:111], v[140:143], v[72:75]
  v_exp_f32 v36, v36
  v_exp_f32 v37, v37
  v_mfma_f32_16x16x32_bf16 v[64:67], v[80:83], v[144:147], 0
  v_exp_f32 v38, v38
  v_exp_f32 v39, v39
  v_mfma_f32_16x16x32_bf16 v[76:79], v[96:99], v[144:147], 0
  v_add_f32 v25, v32, v33
  v_add_f32 v26, v34, v35
  v_add_f32 v27, v36, v37
  v_add_f32 v28, v38, v39
  v_mfma_f32_16x16x32_bf16 v[64:67], v[84:87], v[148:151], v[64:67]
  v_cvt_pk_bf16_f32 v44, v32, v33
  v_cvt_pk_bf16_f32 v45, v34, v35
  v_add_f32 v25, v25, v26
  v_add_f32 v27, v27, v28
  v_mfma_f32_16x16x32_bf16 v[76:79], v[100:103], v[148:151], v[76:79]
  v_cvt_pk_bf16_f32 v46, v36, v37
  v_cvt_pk_bf16_f32 v47, v38, v39
  v_add_f32 v25, v25, v27
  v_add_f32 v22, v22, v25
  v_mfma_f32_16x16x32_bf16 v[64:67], v[88:91], v[152:155], v[64:67]
  v_fma_f32 v32, v60, s31, -v20
  v_fma_f32 v33, v61, s31, -v20
  v_fma_f32 v34, v62, s31, -v20
  v_fma_f32 v35, v63, s31, -v20
  v_fma_f32 v36, v72, s31, -v20
  v_mfma_f32_16x16x32_bf16 v[76:79], v[104:107], v[152:155], v[76:79]
  v_fma_f32 v37, v73, s31, -v20
  v_fma_f32 v38, v74, s31, -v20
  v_fma_f32 v39, v75, s31, -v20
  v_max3_f32 v25, v32, v33, v34
  v_mfma_f32_16x16x32_bf16 v[64:67], v[92:95], v[156:159], v[64:67]
  v_max3_f32 v26, v35, v36, v37
  v_max3_f32 v25, v25, v38, v39
  v_max_f32 v25, v25, v26
  v_cmp_lt_f32 vcc, 0x41000000, v25
  v_mfma_f32_16x16x32_bf16 v[76:79], v[108:111], v[156:159], v[76:79]
  s_cbranch_vccnz L_slowb
L_backb:
  v_exp_f32 v32, v32
  v_exp_f32 v33, v33
  s_waitcnt vmcnt(8)
  ds_read_b64_tr_b16 v[80:81], v11 offset:0
  ds_read_b64_tr_b16 v[82:83], v11 offset:4096
  ds_read_b64_tr_b16 v[84:85], v12 offset:0
  ds_read_b64_tr_b16 v[86:87], v12 offset:4096
  ds_read_b64_tr_b16 v[88:89], v13 offset:0
  ds_read_b64_tr_b16 v[90:91], v13 offset:4096
  ds_read_b64_tr_b16 v[92:93], v14 offset:0
  ds_read_b64_tr_b16 v[94:95], v14 offset:4096
  ds_read_b64_tr_b16 v[96:97], v15 offset:0
  ds_read_b64_tr_b16 v[98:99], v15 offset:4096
  ds_read_b64_tr_b16 v[100:101], v16 offset:0
  ds_read_b64_tr_b16 v[102:103], v16 offset:4096
  ds_read_b64_tr_b16 v[104:105], v17 offset:0
  ds_read_b64_tr_b16 v[106:107], v17 offset:4096
  ds_read_b64_tr_b16 v[108:109], v18 offset:0
  ds_read_b64_tr_b16 v[110:111], v18 offset:4096
  s_waitcnt lgkmcnt(14)
  v_mfma_f32_16x16x32_bf16 v[160:163], v[80:83], v[44:47], v[160:163]
  v_exp_f32 v34, v34
  v_exp_f32 v35, v35
  s_waitcnt lgkmcnt(12)
  v_mfma_f32_16x16x32_bf16 v[172:175], v[84:87], v[44:47], v[172:175]
  v_exp_f32 v36, v36
  v_exp_f32 v37, v37
  s_waitcnt lgkmcnt(10)
  v_mfma_f32_16x16x32_bf16 v[184:187], v[88:91], v[44:47], v[184:187]
  v_exp_f32 v38, v38
  v_exp_f32 v39, v39
  s_waitcnt lgkmcnt(8)
  v_mfma_f32_16x16x32_bf16 v[196:199], v[92:95], v[44:47], v[196:199]
  v_add_f32 v25, v32, v33
  v_add_f32 v26, v34, v35
  v_add_f32 v27, v36, v37
  v_add_f32 v28, v38, v39
  s_waitcnt lgkmcnt(6)
  v_mfma_f32_16x16x32_bf16 v[208:211], v[96:99], v[44:47], v[208:211]
  v_cvt_pk_bf16_f32 v48, v32, v33
  v_cvt_pk_bf16_f32 v49, v34, v35
  v_add_f32 v25, v25, v26
  v_add_f32 v27, v27, v28
  s_waitcnt lgkmcnt(4)
  v_mfma_f32_16x16x32_bf16 v[220:223], v[100:103], v[44:47], v[220:223]
  v_cvt_pk_bf16_f32 v50, v36, v37
  v_cvt_pk_bf16_f32 v51, v38, v39
  v_add_f32 v25, v25, v27
  v_add_f32 v23, v23, v25
  s_waitcnt lgkmcnt(2)
  v_mfma_f32_16x16x32_bf16 v[232:235], v[104:107], v[44:47], v[232:235]
  v_fma_f32 v32, v64, s31, -v21
  v_fma_f32 v33, v65, s31, -v21
  v_fma_f32 v34, v66, s31, -v21
  v_fma_f32 v35, v67, s31, -v21
  v_fma_f32 v36, v76, s31, -v21
  s_waitcnt lgkmcnt(0)
  v_mfma_f32_16x16x32_bf16 v[244:247], v[108:111], v[44:47], v[244:247]
  v_fma_f32 v37, v77, s31, -v21
  v_fma_f32 v38, v78, s31, -v21
  v_fma_f32 v39, v79, s31, -v21
  v_max3_f32 v25, v32, v33, v34
  v_mfma_f32_16x16x32_bf16 v[164:167], v[80:83], v[48:51], v[164:167]
  v_max3_f32 v26, v35, v36, v37
  v_max3_f32 v25, v25, v38, v39
  v_max_f32 v25, v25, v26
  v_cmp_lt_f32 vcc, 0x41000000, v25
  v_mfma_f32_16x16x32_bf16 v[176:179], v[84:87], v[48:51], v[176:179]
  s_cbranch_vccnz L_slowc
L_backc:
  v_exp_f32 v32, v32
  v_exp_f32 v33, v33
  v_mfma_f32_16x16x32_bf16 v[188:191], v[88:91], v[48:51], v[188:191]
  v_exp_f32 v34, v34
  v_exp_f32 v35, v35
  v_mfma_f32_16x16x32_bf16 v[200:203], v[92:95], v[48:51], v[200:203]
  v_exp_f32 v36, v36
  v_exp_f32 v37, v37
  v_mfma_f32_16x16x32_bf16 v[212:215], v[96:99], v[48:51], v[212:215]
  v_exp_f32 v38, v38
  v_exp_f32 v39, v39
  v_mfma_f32_16x16x32_bf16 v[224:227], v[100:103], v[48:51], v[224:227]
  v_add_f32 v25, v32, v33
  v_add_f32 v26, v34, v35
  v_add_f32 v27, v36, v37
  v_add_f32 v28, v38, v39
  v_mfma_f32_16x16x32_bf16 v[236:239], v[104:107], v[48:51], v[236:239]
  v_cvt_pk_bf16_f32 v52, v32, v33
  v_cvt_pk_bf16_f32 v53, v34, v35
  v_add_f32 v25, v25, v26
  v_add_f32 v27, v27, v28
  v_mfma_f32_16x16x32_bf16 v[248:251], v[108:111], v[48:51], v[248:251]
  v_cvt_pk_bf16_f32 v54, v36, v37
  v_cvt_pk_bf16_f32 v55, v38, v39
  v_add_f32 v25, v25, v27
  v_add_f32 v24, v24, v25
  s_add_u32 s42, s33, s29
  s_add_u32 s42, s42, 1
  s_and_b32 s42, s42, 7
  s_lshl_b32 s42, s42, 13
  s_add_u32 s42, s42, s30
  s_cmp_lt_u32 s33, 7
  s_cselect_b32 s22, 524288, 0
  s_add_u32 s35, s32, 8192
  s_mov_b32 m0, s35
  s_add_u32 s34, s42, 4096
  v_mfma_f32_16x16x32_bf16 v[168:171], v[80:83], v[52:55], v[168:171]
  buffer_load_dwordx4 v1, s[20:23], s42 offen offset:0  lds
  v_mfma_f32_16x16x32_bf16 v[180:183], v[84:87], v[52:55], v[180:183]
  buffer_load_dwordx4 v2, s[20:23], s42 offen offset:1024  lds
  v_mfma_f32_16x16x32_bf16 v[192:195], v[88:91], v[52:55], v[192:195]
  buffer_load_dwordx4 v1, s[20:23], s42 offen offset:2048  lds
  v_mfma_f32_16x16x32_bf16 v[204:207], v[92:95], v[52:55], v[204:207]
  buffer_load_dwordx4 v2, s[20:23], s42 offen offset:3072  lds
  v_mfma_f32_16x16x32_bf16 v[216:219], v[96:99], v[52:55], v[216:219]
  s_add_u32 s35, s35, 4096
  s_mov_b32 m0, s35
  s_nop 0
  buffer_load_dwordx4 v1, s[20:23], s34 offen offset:0  lds
  v_mfma_f32_16x16x32_bf16 v[228:231], v[100:103], v[52:55], v[228:231]
  buffer_load_dwordx4 v2, s[20:23], s34 offen offset:1024  lds
  v_mfma_f32_16x16x32_bf16 v[240:243], v[104:107], v[52:55], v[240:243]
  buffer_load_dwordx4 v1, s[20:23], s34 offen offset:2048  lds
  v_mfma_f32_16x16x32_bf16 v[252:255], v[108:111], v[52:55], v[252:255]
  buffer_load_dwordx4 v2, s[20:23], s34 offen offset:3072  lds
  s_add_u32 s33, s33, 1
  s_cmp_lt_u32 s33, 8
  s_cbranch_scc1 L_loop
L_epi:
  s_waitcnt vmcnt(0)
  v_mov_b32 v25, v22
  s_nop 1
  v_permlane32_swap_b32 v22, v25
  v_add_f32 v22, v22, v25
  v_mov_b32 v25, v22
  s_nop 1
  v_permlane16_swap_b32 v22, v25
  v_add_f32 v22, v22, v25
  v_mov_b32 v25, v23
  s_nop 1
  v_permlane32_swap_b32 v23, v25
  v_add_f32 v23, v23, v25
  v_mov_b32 v25, v23
  s_nop 1
  v_permlane16_swap_b32 v23, v25
  v_add_f32 v23, v23, v25
  v_mov_b32 v25, v24
  s_nop 1
  v_permlane32_swap_b32 v24, v25
  v_add_f32 v24, v24, v25
  v_mov_b32 v25, v24
  s_nop 1
  v_permlane16_swap_b32 v24, v25
  v_add_f32 v24, v24, v25
  v_and_b32 v42, 15, v0
  v_lshlrev_b32 v43, 5, v42
  s_lshl_b32 s34, s28, 2
  s_add_u32 s34, s34, 143360
  v_add_u32 v44, s34, v43
  ds_write_b32 v44, v19 offset:0
  ds_write_b32 v44, v22 offset:1536
  ds_write_b32 v44, v20 offset:512
  ds_write_b32 v44, v23 offset:2048
  ds_write_b32 v44, v21 offset:1024
  ds_write_b32 v44, v24 offset:2560
  v_add_u32 v43, 143360, v43
  v_and_b32 v40, 63, v0
  v_lshlrev_b32 v40, 4, v40
  v_add_u32 v41, s32, v40
  v_bfe_u32 v45, v0, 4, 2
  v_lshlrev_b32 v42, 8, v42
  v_lshl_add_u32 v42, v45, 3, v42
  v_cvt_pk_bf16_f32 v64, v160, v161
  v_cvt_pk_bf16_f32 v65, v162, v163
  v_cvt_pk_bf16_f32 v66, v164, v165
  v_cvt_pk_bf16_f32 v67, v166, v167
  v_cvt_pk_bf16_f32 v68, v168, v169
  v_cvt_pk_bf16_f32 v69, v170, v171
  v_cvt_pk_bf16_f32 v70, v172, v173
  v_cvt_pk_bf16_f32 v71, v174, v175
  v_cvt_pk_bf16_f32 v72, v176, v177
  v_cvt_pk_bf16_f32 v73, v178, v179
  v_cvt_pk_bf16_f32 v74, v180, v181
  v_cvt_pk_bf16_f32 v75, v182, v183
  v_cvt_pk_bf16_f32 v76, v184, v185
  v_cvt_pk_bf16_f32 v77, v186, v187
  v_cvt_pk_bf16_f32 v78, v188, v189
  v_cvt_pk_bf16_f32 v79, v190, v191
  v_cvt_pk_bf16_f32 v80, v192, v193
  v_cvt_pk_bf16_f32 v81, v194, v195
  v_cvt_pk_bf16_f32 v82, v196, v197
  v_cvt_pk_bf16_f32 v83, v198, v199
  v_cvt_pk_bf16_f32 v84, v200, v201
  v_cvt_pk_bf16_f32 v85, v202, v203
  v_cvt_pk_bf16_f32 v86, v204, v205
  v_cvt_pk_bf16_f32 v87, v206, v207
  v_cvt_pk_bf16_f32 v88, v208, v209
  v_cvt_pk_bf16_f32 v89, v210, v211
  v_cvt_pk_bf16_f32 v90, v212, v213
  v_cvt_pk_bf16_f32 v91, v214, v215
  v_cvt_pk_bf16_f32 v92, v216, v217
  v_cvt_pk_bf16_f32 v93, v218, v219
  v_cvt_pk_bf16_f32 v94, v220, v221
  v_cvt_pk_bf16_f32 v95, v222, v223
  v_cvt_pk_bf16_f32 v96, v224, v225
  v_cvt_pk_bf16_f32 v97, v226, v227
  v_cvt_pk_bf16_f32 v98, v228, v229
  v_cvt_pk_bf16_f32 v99, v230, v231
  v_cvt_pk_bf16_f32 v100, v232, v233
  v_cvt_pk_bf16_f32 v101, v234, v235
  v_cvt_pk_bf16_f32 v102, v236, v237
  v_cvt_pk_bf16_f32 v103, v238, v239
  v_cvt_pk_bf16_f32 v104, v240, v241
  v_cvt_pk_bf16_f32 v105, v242, v243
  v_cvt_pk_bf16_f32 v106, v244, v245
  v_cvt_pk_bf16_f32 v107, v246, v247
  v_cvt_pk_bf16_f32 v108, v248, v249
  v_cvt_pk_bf16_f32 v109, v250, v251
  v_cvt_pk_bf16_f32 v110, v252, v253
  v_cvt_pk_bf16_f32 v111, v254, v255
  ds_write_b128 v41, v[64:67] offset:0
  ds_write_b128 v41, v[68:71] offset:1024
  ds_write_b128 v41, v[72:75] offset:2048
  ds_write_b128 v41, v[76:79] offset:3072
  ds_write_b128 v41, v[80:83] offset:4096
  ds_write_b128 v41, v[84:87] offset:5120
  ds_write_b128 v41, v[88:91] offset:6144
  ds_write_b128 v41, v[92:95] offset:7168
  ds_write_b128 v41, v[96:99] offset:8192
  ds_write_b128 v41, v[100:103] offset:9216
  ds_write_b128 v41, v[104:107] offset:10240
  ds_write_b128 v41, v[108:111] offset:11264
  s_waitcnt lgkmcnt(0)
  s_barrier
  s_mul_i32 s35, s28, 3
  s_lshl_b32 s42, s28, 5
  s_mov_b32 s33, 0
L_ek:
  s_lshr_b32 s36, s35, 1
  s_lshl_b32 s36, s36, 10
  s_and_b32 s34, s35, 1
  s_lshl_b32 s34, s34, 3
  s_add_u32 s36, s36, s34
  v_add_u32 v44, s36, v40
  v_add_u32 v45, 0x10000, v44
  ds_read_b128 v[48:51], v43
  ds_read_b128 v[52:55], v43 offset:16
  ds_read_b128 v[56:59], v43 offset:1536
  ds_read_b128 v[60:63], v43 offset:1552
  ds_read_b64 v[64:65], v44 offset:0
  ds_read_b64 v[66:67], v44 offset:16384
  ds_read_b64 v[68:69], v44 offset:32768
  ds_read_b64 v[70:71], v44 offset:49152
  ds_read_b64 v[72:73], v45 offset:0
  ds_read_b64 v[74:75], v45 offset:16384
  ds_read_b64 v[76:77], v45 offset:32768
  ds_read_b64 v[78:79], v45 offset:49152
  v_add_u32 v43, 512, v43
  s_waitcnt lgkmcnt(8)
  v_max3_f32 v47, v48, v49, v50
  v_max3_f32 v47, v47, v51, v52
  v_max3_f32 v47, v47, v53, v54
  v_max_f32 v47, v47, v55
  v_sub_f32 v48, v48, v47
  v_sub_f32 v49, v49, v47
  v_sub_f32 v50, v50, v47
  v_sub_f32 v51, v51, v47
  v_sub_f32 v52, v52, v47
  v_sub_f32 v53, v53, v47
  v_sub_f32 v54, v54, v47
  v_sub_f32 v55, v55, v47
  v_exp_f32 v48, v48
  v_exp_f32 v49, v49
  v_exp_f32 v50, v50
  v_exp_f32 v51, v51
  v_exp_f32 v52, v52
  v_exp_f32 v53, v53
  v_exp_f32 v54, v54
  v_exp_f32 v55, v55
  s_nop 0
  v_mul_f32 v47, v48, v56
  v_fmac_f32 v47, v49, v57
  v_fmac_f32 v47, v50, v58
  v_fmac_f32 v47, v51, v59
  v_fmac_f32 v47, v52, v60
  v_fmac_f32 v47, v53, v61
  v_fmac_f32 v47, v54, v62
  v_fmac_f32 v47, v55, v63
  v_rcp_f32 v47, v47
  s_waitcnt lgkmcnt(0)
  v_lshlrev_b32 v80, 16, v64
  v_and_b32 v81, 0xffff0000, v64
  v_lshlrev_b32 v82, 16, v65
  v_and_b32 v83, 0xffff0000, v65
  v_mul_f32 v84, v80, v48
  v_mul_f32 v85, v81, v48
  v_mul_f32 v86, v82, v48
  v_mul_f32 v87, v83, v48
  v_lshlrev_b32 v80, 16, v66
  v_and_b32 v81, 0xffff0000, v66
  v_lshlrev_b32 v82, 16, v67
  v_and_b32 v83, 0xffff0000, v67
  v_fmac_f32 v84, v80, v49
  v_fmac_f32 v85, v81, v49
  v_fmac_f32 v86, v82, v49
  v_fmac_f32 v87, v83, v49
  v_lshlrev_b32 v80, 16, v68
  v_and_b32 v81, 0xffff0000, v68
  v_lshlrev_b32 v82, 16, v69
  v_and_b32 v83, 0xffff0000, v69
  v_fmac_f32 v84, v80, v50
  v_fmac_f32 v85, v81, v50
  v_fmac_f32 v86, v82, v50
  v_fmac_f32 v87, v83, v50
  v_lshlrev_b32 v80, 16, v70
  v_and_b32 v81, 0xffff0000, v70
  v_lshlrev_b32 v82, 16, v71
  v_and_b32 v83, 0xffff0000, v71
  v_fmac_f32 v84, v80, v51
  v_fmac_f32 v85, v81, v51
  v_fmac_f32 v86, v82, v51
  v_fmac_f32 v87, v83, v51
  v_lshlrev_b32 v80, 16, v72
  v_and_b32 v81, 0xffff0000, v72
  v_lshlrev_b32 v82, 16, v73
  v_and_b32 v83, 0xffff0000, v73
  v_fmac_f32 v84, v80, v52
  v_fmac_f32 v85, v81, v52
  v_fmac_f32 v86, v82, v52
  v_fmac_f32 v87, v83, v52
  v_lshlrev_b32 v80, 16, v74
  v_and_b32 v81, 0xffff0000, v74
  v_lshlrev_b32 v82, 16, v75
  v_and_b32 v83, 0xffff0000, v75
  v_fmac_f32 v84, v80, v53
  v_fmac_f32 v85, v81, v53
  v_fmac_f32 v86, v82, v53
  v_fmac_f32 v87, v83, v53
  v_lshlrev_b32 v80, 16, v76
  v_and_b32 v81, 0xffff0000, v76
  v_lshlrev_b32 v82, 16, v77
  v_and_b32 v83, 0xffff0000, v77
  v_fmac_f32 v84, v80, v54
  v_fmac_f32 v85, v81, v54
  v_fmac_f32 v86, v82, v54
  v_fmac_f32 v87, v83, v54
  v_lshlrev_b32 v80, 16, v78
  v_and_b32 v81, 0xffff0000, v78
  v_lshlrev_b32 v82, 16, v79
  v_and_b32 v83, 0xffff0000, v79
  v_fmac_f32 v84, v80, v55
  v_fmac_f32 v85, v81, v55
  v_fmac_f32 v86, v82, v55
  v_fmac_f32 v87, v83, v55
  v_mul_f32 v84, v84, v47
  v_mul_f32 v85, v85, v47
  v_mul_f32 v86, v86, v47
  v_mul_f32 v87, v87, v47
  v_cvt_pk_bf16_f32 v84, v84, v85
  v_cvt_pk_bf16_f32 v85, v86, v87
  buffer_store_dwordx2 v[84:85], v42, s[24:27], s42 offen
  s_add_u32 s42, s42, 4096
  s_add_u32 s35, s35, 1
  s_add_u32 s33, s33, 1
  s_cmp_lt_u32 s33, 3
  s_cbranch_scc1 L_ek
L_end:
  s_endpgm
L_slowa:
  v_max3_f32 v26, v56, v57, v58
  v_max3_f32 v26, v26, v59, v68
  v_max3_f32 v26, v26, v69, v70
  v_max_f32 v26, v26, v71
  v_mov_b32 v25, v26
  s_nop 1
  v_permlane32_swap_b32 v26, v25
  v_max_f32 v26, v26, v25
  v_mov_b32 v25, v26
  s_nop 1
  v_permlane16_swap_b32 v26, v25
  v_max_f32 v26, v26, v25
  v_mul_f32 v26, s31, v26
  v_max_f32 v26, v26, v19
  v_sub_f32 v25, v19, v26
  v_exp_f32 v25, v25
  v_mov_b32 v19, v26
  v_mul_f32 v22, v22, v25
  v_mul_f32 v160, v160, v25
  v_mul_f32 v161, v161, v25
  v_mul_f32 v162, v162, v25
  v_mul_f32 v163, v163, v25
  v_mul_f32 v172, v172, v25
  v_mul_f32 v173, v173, v25
  v_mul_f32 v174, v174, v25
  v_mul_f32 v175, v175, v25
  v_mul_f32 v184, v184, v25
  v_mul_f32 v185, v185, v25
  v_mul_f32 v186, v186, v25
  v_mul_f32 v187, v187, v25
  v_mul_f32 v196, v196, v25
  v_mul_f32 v197, v197, v25
  v_mul_f32 v198, v198, v25
  v_mul_f32 v199, v199, v25
  v_mul_f32 v208, v208, v25
  v_mul_f32 v209, v209, v25
  v_mul_f32 v210, v210, v25
  v_mul_f32 v211, v211, v25
  v_mul_f32 v220, v220, v25
  v_mul_f32 v221, v221, v25
  v_mul_f32 v222, v222, v25
  v_mul_f32 v223, v223, v25
  v_mul_f32 v232, v232, v25
  v_mul_f32 v233, v233, v25
  v_mul_f32 v234, v234, v25
  v_mul_f32 v235, v235, v25
  v_mul_f32 v244, v244, v25
  v_mul_f32 v245, v245, v25
  v_mul_f32 v246, v246, v25
  v_mul_f32 v247, v247, v25
  v_fma_f32 v32, v56, s31, -v19
  v_fma_f32 v33, v57, s31, -v19
  v_fma_f32 v34, v58, s31, -v19
  v_fma_f32 v35, v59, s31, -v19
  v_fma_f32 v36, v68, s31, -v19
  v_fma_f32 v37, v69, s31, -v19
  v_fma_f32 v38, v70, s31, -v19
  v_fma_f32 v39, v71, s31, -v19
  s_branch L_backa
L_slowb:
  v_max3_f32 v26, v60, v61, v62
  v_max3_f32 v26, v26, v63, v72
  v_max3_f32 v26, v26, v73, v74
  v_max_f32 v26, v26, v75
  v_mov_b32 v25, v26
  s_nop 1
  v_permlane32_swap_b32 v26, v25
  v_max_f32 v26, v26, v25
  v_mov_b32 v25, v26
  s_nop 1
  v_permlane16_swap_b32 v26, v25
  v_max_f32 v26, v26, v25
  v_mul_f32 v26, s31, v26
  v_max_f32 v26, v26, v20
  v_sub_f32 v25, v20, v26
  v_exp_f32 v25, v25
  v_mov_b32 v20, v26
  v_mul_f32 v23, v23, v25
  v_mul_f32 v164, v164, v25
  v_mul_f32 v165, v165, v25
  v_mul_f32 v166, v166, v25
  v_mul_f32 v167, v167, v25
  v_mul_f32 v176, v176, v25
  v_mul_f32 v177, v177, v25
  v_mul_f32 v178, v178, v25
  v_mul_f32 v179, v179, v25
  v_mul_f32 v188, v188, v25
  v_mul_f32 v189, v189, v25
  v_mul_f32 v190, v190, v25
  v_mul_f32 v191, v191, v25
  v_mul_f32 v200, v200, v25
  v_mul_f32 v201, v201, v25
  v_mul_f32 v202, v202, v25
  v_mul_f32 v203, v203, v25
  v_mul_f32 v212, v212, v25
  v_mul_f32 v213, v213, v25
  v_mul_f32 v214, v214, v25
  v_mul_f32 v215, v215, v25
  v_mul_f32 v224, v224, v25
  v_mul_f32 v225, v225, v25
  v_mul_f32 v226, v226, v25
  v_mul_f32 v227, v227, v25
  v_mul_f32 v236, v236, v25
  v_mul_f32 v237, v237, v25
  v_mul_f32 v238, v238, v25
  v_mul_f32 v239, v239, v25
  v_mul_f32 v248, v248, v25
  v_mul_f32 v249, v249, v25
  v_mul_f32 v250, v250, v25
  v_mul_f32 v251, v251, v25
  v_fma_f32 v32, v60, s31, -v20
  v_fma_f32 v33, v61, s31, -v20
  v_fma_f32 v34, v62, s31, -v20
  v_fma_f32 v35, v63, s31, -v20
  v_fma_f32 v36, v72, s31, -v20
  v_fma_f32 v37, v73, s31, -v20
  v_fma_f32 v38, v74, s31, -v20
  v_fma_f32 v39, v75, s31, -v20
  s_branch L_backb
L_slowc:
  v_max3_f32 v26, v64, v65, v66
  v_max3_f32 v26, v26, v67, v76
  v_max3_f32 v26, v26, v77, v78
  v_max_f32 v26, v26, v79
  v_mov_b32 v25, v26
  s_nop 1
  v_permlane32_swap_b32 v26, v25
  v_max_f32 v26, v26, v25
  v_mov_b32 v25, v26
  s_nop 1
  v_permlane16_swap_b32 v26, v25
  v_max_f32 v26, v26, v25
  v_mul_f32 v26, s31, v26
  v_max_f32 v26, v26, v21
  v_sub_f32 v25, v21, v26
  v_exp_f32 v25, v25
  v_mov_b32 v21, v26
  v_mul_f32 v24, v24, v25
  v_mul_f32 v168, v168, v25
  v_mul_f32 v169, v169, v25
  v_mul_f32 v170, v170, v25
  v_mul_f32 v171, v171, v25
  v_mul_f32 v180, v180, v25
  v_mul_f32 v181, v181, v25
  v_mul_f32 v182, v182, v25
  v_mul_f32 v183, v183, v25
  v_mul_f32 v192, v192, v25
  v_mul_f32 v193, v193, v25
  v_mul_f32 v194, v194, v25
  v_mul_f32 v195, v195, v25
  v_mul_f32 v204, v204, v25
  v_mul_f32 v205, v205, v25
  v_mul_f32 v206, v206, v25
  v_mul_f32 v207, v207, v25
  v_mul_f32 v216, v216, v25
  v_mul_f32 v217, v217, v25
  v_mul_f32 v218, v218, v25
  v_mul_f32 v219, v219, v25
  v_mul_f32 v228, v228, v25
  v_mul_f32 v229, v229, v25
  v_mul_f32 v230, v230, v25
  v_mul_f32 v231, v231, v25
  v_mul_f32 v240, v240, v25
  v_mul_f32 v241, v241, v25
  v_mul_f32 v242, v242, v25
  v_mul_f32 v243, v243, v25
  v_mul_f32 v252, v252, v25
  v_mul_f32 v253, v253, v25
  v_mul_f32 v254, v254, v25
  v_mul_f32 v255, v255, v25
  v_fma_f32 v32, v64, s31, -v21
  v_fma_f32 v33, v65, s31, -v21
  v_fma_f32 v34, v66, s31, -v21
  v_fma_f32 v35, v67, s31, -v21
  v_fma_f32 v36, v76, s31, -v21
  v_fma_f32 v37, v77, s31, -v21
  v_fma_f32 v38, v78, s31, -v21
  v_fma_f32 v39, v79, s31, -v21
  s_branch L_backc
L_codeend:
  s_endpgm
.section .rodata,"a"
.p2align 6
.amdhsa_kernel standalone__gqa_softmax__near_ridge_kernel
  .amdhsa_next_free_vgpr 256
  .amdhsa_next_free_sgpr 48
  .amdhsa_accum_offset 256
  .amdhsa_group_segment_fixed_size 0
  .amdhsa_kernarg_size 48
  .amdhsa_user_sgpr_count 2
  .amdhsa_user_sgpr_kernarg_segment_ptr 1
  .amdhsa_system_sgpr_workgroup_id_x 1
.end_amdhsa_kernel
```
